```python
import torch

def _softmax(x, axis=-1):
    return torch.softmax(x, dim=axis)

def _gelu(x):
    return torch.nn.functional.gelu(x, approximate='tanh')

def _silu(x):
    return torch.nn.functional.silu(x)

def _sigmoid(x):
    return torch.sigmoid(x)

def _layernorm(x, axis=-1, eps=1e-05):
    m = x.mean(dim=axis, keepdim=True)
    v = x.var(dim=axis, keepdim=True, unbiased=False)
    return (x - m) / torch.sqrt(v + eps)

def _scatter_add(tgt, idx, src, axis=0):
    return tgt.clone().index_add_(axis, idx, src)

def _segment_sum(src, seg, n):
    out = torch.zeros((n,) + src.shape[1:], dtype=src.dtype)
    return out.index_add_(0, seg, src)

def _pad(x, pw):
    flat = tuple((v for pair in reversed(pw) for v in pair))
    return torch.nn.functional.pad(x, flat)
kernel_name = 'gather_scatter__tensor_product_equiv_tfn__graph'

def setup_inputs():

    _w = lambda a: (lambda t: t.to(torch.bfloat16) if t.is_floating_point() else t)(torch.as_tensor(a))
    N, deg, C, L, DE = (10000, 16, 128, 1, 4)
    E = N * deg
    M = (L + 1) ** 2
    src = (lambda lo, hi, *s: torch.randint(lo, hi, s))(0, N, E).to(torch.int64)
    dst = (lambda lo, hi, *s: torch.randint(lo, hi, s))(0, N, E).to(torch.int64)
    r = (lambda *s: torch.randn(*s, dtype=torch.bfloat16) * 0.05)(E, 3)
    r = r / (torch.linalg.norm(r, dim=-1, keepdim=True) + 1e-09)
    rx, ry, rz = (r[:, 0].clone(), r[:, 1].clone(), r[:, 2].clone())
    Ys = [torch.ones((E, 1), dtype=float)]
    if L >= 1:
        Ys.append(r.to(float))
    if L >= 2:
        Ys.append(torch.stack([2 * rx * ry, 2 * ry * rz, (3 * rz * rz - 1.0) / (lambda _x: torch.sqrt(torch.as_tensor(_x)))(3.0), 2 * rx * rz, rx * rx - ry * ry], dim=-1).to(float))
    for _l in range(3, L + 1):
        Ys.append(((lambda *s: torch.randn(*s, dtype=torch.bfloat16) * 0.05)(E, 2 * _l + 1) * 0.3).to(float))
    Y = torch.cat(Ys, dim=-1)
    cg = torch.zeros((M, M, M), dtype=float)
    off = [_l * _l for _l in range(L + 2)]
    for l1 in range(L + 1):
        for l2 in range(L + 1):
            for l3 in range(abs(l1 - l2), min(L, l1 + l2) + 1):
                d1, d2, d3 = (2 * l1 + 1, 2 * l2 + 1, 2 * l3 + 1)
                cg[off[l1]:off[l1 + 1], off[l2]:off[l2 + 1], off[l3]:off[l3 + 1]] = (lambda *s: torch.randn(*s, dtype=torch.bfloat16) * 0.05)(d1, d2, d3) / (lambda _x: torch.sqrt(torch.as_tensor(_x)))(float(d1 * d2))
    return {'x': _w((lambda *s: torch.randn(*s, dtype=torch.bfloat16) * 0.05)(N, C, M) * 0.2), 'src': _w(src), 'dst': _w(dst), 'Y': _w(Y), 'edge_feat': _w((lambda *s: torch.randn(*s, dtype=torch.bfloat16) * 0.05)(E, DE)), 'w_rad': _w((lambda *s: torch.randn(*s, dtype=torch.bfloat16) * 0.05)(DE, C) * (1.0 / max(1.0, DE) ** 0.5)), 'cg': _w(cg), 'w_mix': _w((lambda *s: torch.randn(*s, dtype=torch.bfloat16) * 0.05)(C, C) * (1.0 / max(1.0, C) ** 0.5))}

def reference(x, src, dst, Y, edge_feat, w_rad, cg, w_mix):
    N, C, M = (x.shape[0], x.shape[1], x.shape[2])
    R = _silu(edge_feat @ w_rad)
    xs = x[src]
    tp = torch.einsum('eci,ef,ifo->eco', xs, Y, cg)
    msg = R[:, :, None] * tp
    agg = _segment_sum(msg.reshape(-1, C * M), dst, N).reshape(N, C, M)
    return torch.einsum('ncm,cd->ndm', agg, w_mix)
```

```asm
; @launch grid=(256,1,1) block=(512,1,1) lds=134144
.amdgcn_target "amdgcn-amd-amdhsa--gfx950"
.text
.globl gather_scatter__tensor_product_equiv_tfn__graph_kernel
.p2align 8
.type gather_scatter__tensor_product_equiv_tfn__graph_kernel,@function
gather_scatter__tensor_product_equiv_tfn__graph_kernel:
    s_cmp_ge_u32 s2, 256
    s_cbranch_scc1 K_END
    s_load_dwordx16 s[32:47], s[0:1], 0
    s_load_dwordx4 s[48:51], s[0:1], 64
    s_load_dwordx2 s[52:53], s[0:1], 80
    v_lshrrev_b32 v164, 6, v0
    v_and_b32 v1, 63, v0
    v_readfirstlane_b32 s55, v164
    v_lshlrev_b32 v207, 4, v0
    v_lshlrev_b32 v148, 3, v0
    s_cmp_lt_u32 s55, 6
    s_cbranch_scc1 NOCPF
    s_getpc_b64 s[84:85]
CPF_BASE:
    v_and_b32 v231, 127, v0
    v_min_u32 v231, (CODE_END-CPF_BASE)/128, v231
    v_lshlrev_b32 v231, 7, v231
    global_load_dword v231, v231, s[84:85]
NOCPF:
    v_mov_b64 v[216:217], 0
    v_mov_b64 v[218:219], 0
    ds_write_b128 v207, v[216:219] offset:31744
    ds_write_b64 v148, v[216:217]
    v_lshlrev_b32 v2, 4, v1
    v_lshlrev_b32 v3, 3, v1
    s_mul_i32 s59, s2, 2500
    s_mul_i32 s60, s2, 5000
    s_mov_b32 s26, 640000
    s_mov_b32 s27, 0x20000
    s_mov_b32 s30, 640000
    s_mov_b32 s31, 0x20000
    s_mov_b32 s18, 1280000
    s_mov_b32 s19, 0x20000
    s_mov_b32 s22, 1280000
    s_mov_b32 s23, 0x20000
    s_mov_b32 s10, 9437184
    s_mov_b32 s11, 0x20000
    s_mov_b32 s86, 0xaaaaaaaa
    s_mov_b32 s87, 0xaaaaaaaa
    v_cmp_gt_u32 vcc, 313, v0
    s_mov_b64 s[76:77], vcc
    v_cmp_gt_u32 vcc, 312, v0
    s_mov_b64 s[78:79], vcc
    v_mov_b32 v116, 1
    v_mov_b64 v[4:5], 0
    v_mov_b64 v[6:7], 0
    v_mov_b64 v[8:9], 0
    v_mov_b64 v[10:11], 0
    v_mov_b64 v[12:13], 0
    v_mov_b64 v[14:15], 0
    v_mov_b64 v[16:17], 0
    v_mov_b64 v[18:19], 0
    v_mov_b64 v[20:21], 0
    v_mov_b64 v[22:23], 0
    v_mov_b64 v[24:25], 0
    v_mov_b64 v[26:27], 0
    v_mov_b64 v[28:29], 0
    v_mov_b64 v[30:31], 0
    v_mov_b64 v[32:33], 0
    v_mov_b64 v[34:35], 0
    v_mov_b64 v[36:37], 0
    v_mov_b64 v[38:39], 0
    v_mov_b64 v[40:41], 0
    v_mov_b64 v[42:43], 0
    v_mov_b64 v[44:45], 0
    v_mov_b64 v[46:47], 0
    v_mov_b64 v[48:49], 0
    v_mov_b64 v[50:51], 0
    s_waitcnt lgkmcnt(0)
    s_mov_b64 s[24:25], s[36:37]
    s_mov_b64 s[28:29], s[34:35]
    s_add_u32 s8, s52, 0
    s_addc_u32 s9, s53, 0
    s_cmp_ge_u32 s55, 5
    s_cbranch_scc1 NOIN
    buffer_load_dwordx2 v[52:53], v148, s[24:27], s59 offen
    buffer_load_dwordx2 v[54:55], v148, s[28:31], s59 offen
NOIN:
    buffer_load_dword v203, off, s[8:11], 0
    s_mov_b64 s[16:17], s[38:39]
    s_mov_b64 s[20:21], s[40:41]
    s_barrier
    s_cbranch_scc1 NOIN2
    buffer_load_dwordx4 v[56:59], v207, s[16:19], s60 offen
    buffer_load_dwordx4 v[60:63], v207, s[20:23], s60 offen
NOIN2:
    ds_write_b128 v207, v[216:219] offset:8192
    ds_write_b128 v207, v[216:219] offset:16384
    v_mov_b32 v164, 40
    v_mov_b32 v165, 40
    ds_write_b64 v148, v[164:165] offset:4096
    s_lshl_b32 s59, s55, 10
    v_add_u32 v149, s59, v2
    v_add_u32 v150, s59, v149
    s_lshl_b32 s59, s55, 2
    v_mov_b32 v152, s59
    s_lshl_b32 s59, s55, 5
    v_and_b32 v153, 16, v2
    v_add_u32 v154, s59, v153
    v_and_b32 v155, 56, v1
    v_add_u32 v156, 64, v155
    v_mov_b32 v157, 2147418112
    v_add_u32 v161, 8192, v207
    v_add_u32 v162, 16384, v207
    v_add_u32 v163, 24576, v207
    s_mul_i32 s61, s2, 8448
    s_add_u32 s61, s61, 4096
    s_mul_i32 s68, s2, 16640
    s_add_u32 s68, s68, 3145728
    s_lshl_b32 s69, s55, 8
    s_add_u32 s69, s69, s2
    s_lshl_b32 s69, s69, 6
    s_add_u32 s69, s69, 8388608
    s_and_b32 s64, s2, 7
    s_lshl_b32 s59, s64, 5
    s_lshr_b32 s67, s2, 3
    s_add_u32 s93, s67, s59
    s_lshl_b32 s93, s93, 5
    s_add_u32 s93, s93, 4096
    s_lshl_b32 s92, s67, 3
    s_add_u32 s92, s92, s55
    s_lshl_b32 s67, s67, 6
    s_mov_b32 s54, s2
    v_lshrrev_b32 v205, 1, v0
    v_mul_u32_u24 v204, 8448, v205
    v_add_u32 v204, v204, v153
    v_mul_u32_u24 v206, 16640, v205
    s_lshl_b32 s59, s64, 11
    s_add_u32 s59, s59, 3145728
    v_add_u32 v206, s59, v206
    v_lshl_add_u32 v205, v205, 6, v153
    s_lshl_b32 s75, s64, 14
    s_add_u32 s75, s75, 8388608
    s_mov_b32 s73, 0x05040100
    s_mov_b32 s74, 0x07060302
    v_lshrrev_b32 v158, 4, v0
    v_mul_u32_u24 v158, 288, v158
    v_bfe_u32 v160, v0, 2, 2
    v_lshl_add_u32 v158, v160, 6, v158
    v_and_b32 v236, 3, v0
    v_lshl_add_u32 v158, v236, 3, v158
    v_add_u32 v158, 90624, v158
    v_lshrrev_b32 v221, 4, v1
    v_lshl_add_u32 v160, v221, 3, v160
    v_mul_u32_u24 v160, 288, v160
    v_lshl_add_u32 v160, v236, 3, v160
    s_and_b32 s60, s55, 3
    s_lshl_b32 s59, s60, 6
    s_add_u32 s59, s59, 90624
    v_add_u32 v160, s59, v160
    v_lshrrev_b32 v233, 1, v3
    s_cmp_ge_u32 s55, 5
    s_cbranch_scc1 HELPER
    s_waitcnt vmcnt(4)
    v_min_u32 v52, 9999, v52
    v_and_b32 v120, 7, v52
    v_bfe_u32 v118, v52, 3, 5
    v_lshl_or_b32 v118, v120, 5, v118
    v_lshlrev_b32 v119, 2, v118
    v_lshlrev_b32 v121, 2, v120
    s_mov_b64 exec, s[76:77]
    ds_add_rtn_u32 v122, v119, v116 offset:3072
    ds_add_rtn_u32 v123, v121, v116 offset:2304
    v_min_u32 v53, 9999, v53
    v_and_b32 v128, 7, v53
    v_bfe_u32 v126, v53, 3, 5
    v_lshl_or_b32 v126, v128, 5, v126
    v_lshlrev_b32 v127, 2, v126
    v_lshlrev_b32 v129, 2, v128
    s_mov_b64 exec, s[78:79]
    ds_add_rtn_u32 v130, v127, v116 offset:3072
    ds_add_rtn_u32 v131, v129, v116 offset:2304
    s_mov_b64 exec, s[76:77]
    s_waitcnt vmcnt(3)
    v_min_u32 v54, 9999, v54
    v_mul_u32_u24 v124, 53687, v54
    v_lshrrev_b32 v124, 26, v124
    v_lshl_or_b32 v124, v54, 10, v124
    v_lshrrev_b32 v125, 8, v52
    v_or_b32 v119, 64, v125
    v_lshl_or_b32 v124, v119, 3, v124
    v_min_u32 v55, 9999, v55
    v_mul_u32_u24 v132, 53687, v55
    v_lshrrev_b32 v132, 26, v132
    v_lshl_or_b32 v132, v55, 10, v132
    v_lshrrev_b32 v133, 8, v53
    v_or_b32 v127, 64, v133
    v_lshl_or_b32 v132, v127, 3, v132
    s_waitcnt lgkmcnt(2)
    v_lshrrev_b32 v119, 4, v123
    v_and_or_b32 v119, v119, -8, v122
    v_cmp_gt_u32 vcc, 7, v119
    v_lshl_or_b32 v124, v123, 24, v124
    v_mul_u32_u24 v119, 18, v122
    v_and_b32 v119, 28, v119
    v_lshl_add_u32 v119, v118, 5, v119
    s_andn2_b64 s[80:81], s[76:77], vcc
    s_and_b64 exec, s[76:77], vcc
    ds_write_b32 v119, v124 offset:31744
    s_mov_b64 exec, s[76:77]
    s_waitcnt lgkmcnt(0)
    v_lshrrev_b32 v127, 4, v131
    v_and_or_b32 v127, v127, -8, v130
    v_cmp_gt_u32 vcc, 7, v127
    v_lshl_or_b32 v132, v131, 24, v132
    v_mul_u32_u24 v127, 18, v130
    v_and_b32 v127, 28, v127
    v_lshl_add_u32 v127, v126, 5, v127
    s_andn2_b64 s[82:83], s[78:79], vcc
    s_and_b64 exec, s[78:79], vcc
    ds_write_b32 v127, v132 offset:31744
    s_mov_b64 exec, -1
    global_load_dwordx4 v[64:67], v207, s[46:47]
    global_load_dwordx4 v[68:71], v161, s[46:47]
    global_load_dwordx4 v[72:75], v162, s[46:47]
    global_load_dwordx4 v[76:79], v163, s[46:47]
    s_waitcnt vmcnt(6)
    s_branch JOIN2
HELPER:
    s_cmp_eq_u32 s55, 7
    s_cbranch_scc1 HELP7
    global_load_dword v52, v233, s[42:43] offset:0
    global_load_dword v53, v233, s[42:43] offset:256
    global_load_dword v54, v233, s[42:43] offset:512
    global_load_dword v55, v233, s[42:43] offset:768
    global_load_dword v56, v233, s[42:43]
    s_branch HELP_W
HELP7:
    v_lshlrev_b32 v164, 5, v236
    v_bfe_u32 v165, v0, 2, 2
    v_lshl_add_u32 v164, v165, 1, v164
    global_load_ushort v56, v164, s[44:45] offset:0
    global_load_ushort v57, v164, s[44:45] offset:8
    global_load_ushort v58, v164, s[44:45] offset:16
    global_load_ushort v59, v164, s[44:45] offset:24
    s_getpc_b64 s[84:85]
TBL_BASE:
    v_min_u32 v164, 39, v1
    s_and_b32 s3, s2, 0xf0
    s_cselect_b32 s3, 0, 160
    s_add_u32 s3, s3, rank_table-TBL_BASE
    v_lshl_add_u32 v164, v164, 2, s3
    global_load_dword v60, v164, s[84:85]
HELP_W:
    global_load_dwordx4 v[64:67], v207, s[46:47]
    global_load_dwordx4 v[68:71], v161, s[46:47]
    global_load_dwordx4 v[72:75], v162, s[46:47]
    global_load_dwordx4 v[76:79], v163, s[46:47]
    s_waitcnt vmcnt(9)
JOIN2:
    v_add_u32 v203, 1, v203
    v_lshl_or_b32 v202, v203, 1, 1
    s_waitcnt lgkmcnt(0)
    s_barrier
    ds_read_b128 v[208:211], v149 offset:31744
    ds_read_b32 v152, v152 offset:2304
    s_waitcnt lgkmcnt(1)
    v_add3_u32 v164, v208, v209, v210
    v_add_u32 v164, v164, v211
    s_nop 1
    v_add_u32_dpp v164, v164, v164 quad_perm:[1,0,3,2] row_mask:0xf bank_mask:0xf
    v_sub_u32 v164, v202, v164
    v_cndmask_b32 v211, v211, v164, s[86:87]
    buffer_store_dwordx4 v[208:211], v149, s[8:11], s61 offen sc1
    s_cmp_ge_u32 s55, 5
    s_waitcnt vmcnt(5)
    s_cbranch_scc1 CONSTS
    s_mov_b64 exec, s[76:77]
    v_and_b32 v122, 127, v123
    v_lshl_or_b32 v122, v120, 7, v122
    v_lshlrev_b32 v122, 4, v122
    v_and_b32 v130, 127, v131
    v_lshl_or_b32 v130, v128, 7, v130
    v_lshlrev_b32 v130, 4, v130
    v_swap_b32 v58, v60
    v_swap_b32 v59, v61
    ds_write_b128 v122, v[56:59] offset:39936
    s_mov_b64 exec, s[78:79]
    ds_write_b128 v130, v[60:63] offset:39936
    s_mov_b64 exec, -1
    s_branch NOSTAGE
CONSTS:
    s_cmp_eq_u32 s55, 7
    s_cbranch_scc1 CONST7
    s_sub_u32 s59, 6, s55
    s_lshl_b32 s59, s59, 4
    v_lshlrev_b32 v124, s59, v52
    v_and_b32 v124, 0xffff0000, v124
    v_mul_f32 v124, 0xbfb8aa3b, v124
    v_lshlrev_b32 v125, s59, v53
    v_and_b32 v125, 0xffff0000, v125
    v_mul_f32 v125, 0xbfb8aa3b, v125
    v_lshlrev_b32 v126, s59, v54
    v_and_b32 v126, 0xffff0000, v126
    v_mul_f32 v126, 0xbfb8aa3b, v126
    v_lshlrev_b32 v127, s59, v55
    v_and_b32 v127, 0xffff0000, v127
    v_mul_f32 v127, 0xbfb8aa3b, v127
    v_cvt_pk_bf16_f32 v188, v124, v125
    v_lshlrev_b32 v128, 16, v188
    v_and_b32 v129, 0xffff0000, v188
    v_sub_f32 v128, v124, v128
    v_sub_f32 v129, v125, v129
    v_cvt_pk_bf16_f32 v192, v128, v129
    v_cvt_pk_bf16_f32 v189, v126, v127
    v_lshlrev_b32 v128, 16, v189
    v_and_b32 v129, 0xffff0000, v189
    v_sub_f32 v128, v126, v128
    v_sub_f32 v129, v127, v129
    v_cvt_pk_bf16_f32 v193, v128, v129
    s_sub_u32 s59, s55, 5
    s_lshl_b32 s59, s59, 3
    v_add_u32 v124, s59, v2
    ds_write_b64 v124, v[188:189] offset:28672
    ds_write_b64 v124, v[192:193] offset:29696
    s_branch NOSTAGE
CONST7:
    v_lshl_or_b32 v196, v57, 16, v56
    v_lshl_or_b32 v197, v59, 16, v58
    v_mov_b32 v198, 0xbfb8aa3b
    v_mov_b32 v199, 0xbfb8aa3b
    ds_write_b128 v2, v[196:199] offset:30720
    ds_write_b32 v233, v60 offset:2816
NOSTAGE:
    s_waitcnt lgkmcnt(0)
    s_barrier
    ds_read_b128 v[140:143], v150 offset:39936
    ds_read_b128 v[144:147], v150 offset:40960
    v_cmp_lt_u32 vcc, v155, v152
    v_cmp_lt_u32 s[84:85], v156, v152
    s_cmp_ge_u32 s55, 5
    v_cndmask_b32 v155, v157, v150, vcc
    v_cndmask_b32 v156, v157, v150, s[84:85]
    s_waitcnt lgkmcnt(1)
    buffer_store_dwordx4 v[140:143], v155, s[8:11], s68 offen offset:0 sc1
    s_waitcnt lgkmcnt(0)
    buffer_store_dwordx4 v[144:147], v156, s[8:11], s68 offen offset:1024 sc1
    s_cbranch_scc1 LATE_DONE
    s_or_b64 s[84:85], s[80:81], s[82:83]
    s_cbranch_scc0 LATE_DONE
    s_mov_b64 exec, s[80:81]
    ds_add_rtn_u32 v122, v121, v116 offset:2336
    s_mov_b64 exec, s[82:83]
    ds_add_rtn_u32 v130, v129, v116 offset:2336
    s_mov_b64 exec, -1
    v_add_u32 v125, 1, v125
    v_and_b32 v119, 31, v118
    v_lshl_or_b32 v125, v119, 6, v125
    v_lshrrev_b32 v124, 10, v124
    v_lshl_or_b32 v125, v124, 11, v125
    v_lshrrev_b32 v119, 4, v123
    v_add_u32 v133, 1, v133
    v_and_b32 v127, 31, v126
    v_lshl_or_b32 v133, v127, 6, v133
    v_lshrrev_b32 v132, 10, v132
    v_lshl_or_b32 v133, v132, 11, v133
    v_lshrrev_b32 v127, 4, v131
    s_waitcnt lgkmcnt(0)
    v_and_or_b32 v119, v119, -8, v122
    v_cmp_gt_u32 vcc, 7, v119
    v_mul_u32_u24 v119, 18, v122
    v_and_b32 v119, 28, v119
    v_cndmask_b32 v119, 4, v119, vcc
    v_cndmask_b32 v125, 63, v125, vcc
    v_lshl_add_u32 v119, v120, 5, v119
    s_mov_b64 exec, s[80:81]
    ds_or_b32 v119, v125 offset:2560
    s_mov_b64 exec, -1
    v_and_or_b32 v127, v127, -8, v130
    v_cmp_gt_u32 vcc, 7, v127
    v_mul_u32_u24 v127, 18, v130
    v_and_b32 v127, 28, v127
    v_cndmask_b32 v127, 4, v127, vcc
    v_cndmask_b32 v133, 63, v133, vcc
    v_lshl_add_u32 v127, v128, 5, v127
    s_mov_b64 exec, s[82:83]
    ds_or_b32 v127, v133 offset:2560
    s_mov_b64 exec, -1
LATE_DONE:
    s_waitcnt vmcnt(3)
    v_perm_b32 v84, v65, v64, s73
    v_perm_b32 v85, v67, v66, s73
    v_perm_b32 v86, v65, v64, s74
    v_perm_b32 v87, v67, v66, s74
    ds_write2_b64 v158, v[84:85], v[86:87] offset0:0 offset1:4
    v_add_u32 v158, 9216, v158
    v_perm_b32 v88, v69, v68, s73
    v_perm_b32 v89, v71, v70, s73
    v_perm_b32 v90, v69, v68, s74
    v_perm_b32 v91, v71, v70, s74
    ds_write2_b64 v158, v[88:89], v[90:91] offset0:0 offset1:4
    v_add_u32 v158, 9216, v158
    v_perm_b32 v92, v73, v72, s73
    v_perm_b32 v93, v75, v74, s73
    v_perm_b32 v94, v73, v72, s74
    v_perm_b32 v95, v75, v74, s74
    ds_write2_b64 v158, v[92:93], v[94:95] offset0:0 offset1:4
    v_add_u32 v158, 9216, v158
    v_perm_b32 v96, v77, v76, s73
    v_perm_b32 v97, v79, v78, s73
    v_perm_b32 v98, v77, v76, s74
    v_perm_b32 v99, v79, v78, s74
    ds_write2_b64 v158, v[96:97], v[98:99] offset0:0 offset1:4
    s_mov_b32 s12, s48
    s_mov_b32 s13, s49
    s_mov_b32 s14, 10240000
    s_mov_b32 s15, 0x20000
    s_mov_b32 s4, s32
    s_or_b32 s5, s33, 0x100000
    s_mov_b32 s6, 64
    s_mov_b32 s7, 0x800000
    s_mov_b32 s56, 0
    s_mov_b32 s57, 0
    s_mov_b32 s62, 64
    s_mov_b32 s66, 0x1ff
    s_mov_b32 s73, 0x05010400
    s_mov_b32 s74, 0x07030602
    s_cmp_eq_u32 s2, 0
    s_cselect_b32 s63, 0, 1
    s_mov_b32 s58, 0
    s_and_b32 s59, s55, 4
    v_mov_b32 v227, s59
    v_and_b32 v220, 15, v1
    v_mul_u32_u24 v225, 272, v220
    v_lshl_add_u32 v225, v221, 4, v225
    s_mul_i32 s61, s59, 5440
    s_add_u32 s61, s61, 90624
    v_add_u32 v225, s61, v225
    s_mul_i32 s61, s59, 20
    v_lshl_add_u32 v221, v221, 2, s61
    s_mul_i32 s61, s55, 5440
    s_add_u32 s61, s61, 90624
    v_add_u32 v226, s61, v233
    s_lshl_b32 s61, s54, 10
    s_lshl_b32 s60, s60, 8
    s_add_u32 s61, s61, s60
    v_lshl_add_u32 v220, v220, 4, s61
    s_waitcnt lgkmcnt(0)
    s_barrier
    ds_read_b128 v[212:215], v154 offset:2560
    s_waitcnt lgkmcnt(0)
    v_add3_u32 v164, v212, v213, v214
    v_add_u32 v164, v164, v215
    s_nop 1
    v_add_u32_dpp v164, v164, v164 quad_perm:[1,0,3,2] row_mask:0xf bank_mask:0xf
    v_sub_u32 v164, v202, v164
    v_cndmask_b32 v215, v215, v164, s[86:87]
    s_mov_b64 exec, 3
    s_waitcnt vmcnt(0)
    buffer_store_dwordx4 v[212:215], v2, s[8:11], s69 offen sc1
    s_mov_b64 exec, -1
    buffer_load_dwordx4 v[208:211], v204, s[8:11], s93 offen sc1
    ds_read_b32 v222, v233 offset:2816
    ds_read_b128 v[188:191], v2 offset:28672
    ds_read_b128 v[192:195], v2 offset:29696
    ds_read_b128 v[196:199], v2 offset:30720
    ds_read_b64_tr_b16 v[84:85], v160 offset:0
    ds_read_b64_tr_b16 v[86:87], v160 offset:1152
    ds_read_b64_tr_b16 v[88:89], v160 offset:32
    ds_read_b64_tr_b16 v[90:91], v160 offset:1184
    ds_read_b64_tr_b16 v[92:93], v160 offset:9216
    ds_read_b64_tr_b16 v[94:95], v160 offset:10368
    ds_read_b64_tr_b16 v[96:97], v160 offset:9248
    ds_read_b64_tr_b16 v[98:99], v160 offset:10400
    s_waitcnt lgkmcnt(4)
    ds_read_b64_tr_b16 v[100:101], v160 offset:18432
    ds_read_b64_tr_b16 v[102:103], v160 offset:19584
    ds_read_b64_tr_b16 v[104:105], v160 offset:18464
    ds_read_b64_tr_b16 v[106:107], v160 offset:19616
    ds_read_b64_tr_b16 v[108:109], v160 offset:27648
    ds_read_b64_tr_b16 v[110:111], v160 offset:28800
    ds_read_b64_tr_b16 v[112:113], v160 offset:27680
    ds_read_b64_tr_b16 v[114:115], v160 offset:28832
    s_lshl_b32 s59, s55, 9
    v_mov_b32 v239, s59
    v_add_u32 v232, s59, v233
    v_lshlrev_b32 v234, 2, v232
    s_mul_i32 s64, s55, 7296
    s_add_u32 s64, s64, 31744
    v_lshrrev_b32 v71, 2, v1
    v_mul_u32_u24 v71, 192, v71
    v_add_u32 v71, s64, v71
    v_lshl_add_u32 v235, v236, 2, v71
    v_lshl_add_u32 v237, v236, 3, v71
    v_lshl_add_u32 v238, v236, 5, v71
    v_add_u32 v236, v236, v71
    s_mul_i32 s59, s55, 5
    v_add_u32 v240, s59, v1
    v_cmp_gt_u32 vcc, 40, v1
    v_subrev_u32 v241, 40, v240
    v_min_u32 v240, v240, v241
    v_cndmask_b32 v240, 63, v240, vcc
    v_sub_u32 v241, 63, v240
    v_lshlrev_b32 v240, 3, v240
    v_lshrrev_b32 v228, 3, v1
    v_and_b32 v229, 7, v0
    v_lshlrev_b32 v229, 7, v229
    s_and_b32 s59, s2, 3
    s_lshl_b32 s59, s59, 10
    v_add_u32 v229, s59, v229
    s_mul_i32 s84, s92, 3
    s_add_u32 s84, s84, 0
    v_min_u32 v230, 2, v228
    v_add_u32 v230, s84, v230
    v_mul_u32_u24 v230, 4096, v230
    v_and_b32 v230, 0xfffffc00, v230
    v_add_u32 v230, v230, v229
    v_mov_b32 v151, 1
    v_mov_b32 v159, 1
    v_mov_b32 v167, 1
    v_mov_b32 v175, 1
    s_waitcnt vmcnt(0)
POLL:
    v_add3_u32 v52, v208, v209, v210
    v_add_u32 v52, v52, v211
    s_nop 1
    v_add_u32_dpp v52, v52, v52 quad_perm:[1,0,3,2] row_mask:0xf bank_mask:0xf
    v_cmp_ne_u32 vcc, v202, v52
    s_cbranch_vccnz REPOLL
    global_load_dword v231, v230, s[32:33]
    v_cndmask_b32 v211, v211, 0, s[86:87]
BATCH:
    v_cmp_ne_u32 s[76:77], 0, v208
    v_lshlrev_b32 v148, 2, v208
    v_and_b32 v149, 0x1f8, v208
    v_lshlrev_b32 v150, v148, 1
    v_cmp_ne_u32 s[78:79], 0, v209
    v_lshlrev_b32 v156, 2, v209
    v_and_b32 v157, 0x1f8, v209
    v_lshlrev_b32 v158, v156, 1
    v_cmp_ne_u32 s[80:81], 0, v210
    v_lshlrev_b32 v164, 2, v210
    v_and_b32 v165, 0x1f8, v210
    v_lshlrev_b32 v166, v164, 1
    v_cmp_ne_u32 s[82:83], 0, v211
    v_lshlrev_b32 v172, 2, v211
    v_and_b32 v173, 0x1f8, v211
    v_lshlrev_b32 v174, v172, 1
    s_mov_b64 exec, s[76:77]
    ds_add_rtn_u64 v[152:153], v149, v[150:151] offset:0
    s_mov_b64 exec, s[78:79]
    ds_add_rtn_u64 v[160:161], v157, v[158:159] offset:0
    s_mov_b64 exec, s[80:81]
    ds_add_rtn_u64 v[168:169], v165, v[166:167] offset:0
    s_mov_b64 exec, s[82:83]
    ds_add_rtn_u64 v[176:177], v173, v[174:175] offset:0
    s_mov_b64 exec, -1
    s_mov_b64 s[88:89], 0
    s_mov_b32 s61, 0x01010100
    s_mov_b32 s60, 0x01010101
    s_waitcnt lgkmcnt(0)
    s_barrier
    ds_read_b64 v[52:53], v240 offset:0
    buffer_load_dwordx4 v[212:215], v205, s[8:11], s75 offen sc1
    v_and_b32 v150, 0x1ff, v208
    v_bfe_u32 v152, v152, v148, 4
    v_and_b32 v158, 0x1ff, v209
    v_bfe_u32 v160, v160, v156, 4
    v_and_b32 v166, 0x1ff, v210
    v_bfe_u32 v168, v168, v164, 4
    v_and_b32 v174, 0x1ff, v211
    v_bfe_u32 v176, v176, v172, 4
    s_waitcnt lgkmcnt(0)
    v_min_u32 v56, 0xffff, v53
    v_mad_u32_u24 v54, v56, s62, v241
    v_lshrrev_b32 v60, 4, v52
    v_readlane_b32 s68, v54, 0
    v_readlane_b32 s69, v54, 1
    v_readlane_b32 s70, v54, 2
    v_readlane_b32 s71, v54, 3
    v_readlane_b32 s72, v54, 4
    v_and_b32 v60, 0x0f0f0f0f, v60
    v_and_b32 v61, 0x0f0f0f0f, v52
    v_cmp_lt_u32 vcc, s68, v54
    s_bcnt1_i32_b64 s68, vcc
    v_cmp_lt_u32 vcc, s69, v54
    s_bcnt1_i32_b64 s69, vcc
    v_cmp_lt_u32 vcc, s70, v54
    s_bcnt1_i32_b64 s70, vcc
    v_cmp_lt_u32 vcc, s71, v54
    s_bcnt1_i32_b64 s71, vcc
    v_cmp_lt_u32 vcc, s72, v54
    s_bcnt1_i32_b64 s72, vcc
    v_perm_b32 v52, v60, v61, s73
    v_perm_b32 v53, v60, v61, s74
    v_readlane_b32 s68, v222, s68
    v_readlane_b32 s69, v222, s69
    v_readlane_b32 s70, v222, s70
    v_readlane_b32 s71, v222, s71
    v_readlane_b32 s72, v222, s72
    v_sad_u8 v60, v52, 0, 0
    v_sad_u8 v61, v53, 0, v60
    v_writelane_b32 v55, s68, 0
    v_writelane_b32 v55, s69, 1
    v_writelane_b32 v55, s70, 2
    v_writelane_b32 v55, s71, 3
    v_writelane_b32 v55, s72, 4
    s_mov_b64 exec, 31
    v_bfe_u32 v64, v55, 6, 6
    ds_add_rtn_u64 v[58:59], v64, v[52:53] offset:512
    ds_write_b16 v240, v55 offset:1536
    v_mul_lo_u32 v62, v52, s61
    v_mul_lo_u32 v63, v53, s61
    v_mul_lo_u32 v60, v60, s60
    v_sub_u32 v61, v56, v61
    v_add_u32 v63, v63, v60
    ds_add_u64 v64, v[62:63] offset:576
    v_lshl_add_u32 v56, v61, 8, v56
    v_lshrrev_b32 v64, 1, v64
    ds_add_u32 v64, v56 offset:640
    v_lshrrev_b32 v64, 16, v55
    ds_write_b32 v64, v240 offset:2048
    s_waitcnt lgkmcnt(4)
    ds_write_b64 v240, v[58:59] offset:1024
    s_mov_b64 exec, -1
    v_lshrrev_b32 v151, 24, v208
    v_lshl_add_u32 v151, v151, 4, v206
    v_lshrrev_b32 v159, 24, v209
    v_lshl_add_u32 v159, v159, 4, v206
    v_lshrrev_b32 v167, 24, v210
    v_lshl_add_u32 v167, v167, 4, v206
    v_lshrrev_b32 v175, 24, v211
    v_lshl_add_u32 v175, v175, 4, v206
    s_waitcnt lgkmcnt(0)
    s_barrier
    ds_read_u16 v155, v149 offset:1536
    ds_read_u16 v163, v157 offset:1536
    ds_read_u16 v171, v165 offset:1536
    ds_read_u16 v179, v173 offset:1536
    ds_read_u8 v154, v150 offset:1024
    ds_read_u8 v162, v158 offset:1024
    ds_read_u8 v170, v166 offset:1024
    ds_read_u8 v178, v174 offset:1024
    s_waitcnt lgkmcnt(7)
    v_lshrrev_b32 v149, 6, v155
    v_and_or_b32 v149, v208, 7, v149
    ds_read_u8 v153, v149 offset:576
    s_waitcnt lgkmcnt(7)
    v_lshrrev_b32 v157, 6, v163
    v_and_or_b32 v157, v209, 7, v157
    ds_read_u8 v161, v157 offset:576
    s_waitcnt lgkmcnt(7)
    v_lshrrev_b32 v165, 6, v171
    v_and_or_b32 v165, v210, 7, v165
    ds_read_u8 v169, v165 offset:576
    s_waitcnt lgkmcnt(7)
    v_lshrrev_b32 v173, 6, v179
    v_and_or_b32 v173, v211, 7, v173
    ds_read_u8 v177, v173 offset:576
    v_bfi_b32 v150, s66, v155, v208
    v_and_b32 v155, 0xe00, v155
    v_bfi_b32 v158, s66, v163, v209
    v_and_b32 v163, 0xe00, v163
    v_bfi_b32 v166, s66, v171, v210
    v_and_b32 v171, 0xe00, v171
    v_bfi_b32 v174, s66, v179, v211
    v_and_b32 v179, 0xe00, v179
    v_lshrrev_b32 v52, 7, v239
    v_mov_b32 v53, 8
    s_waitcnt lgkmcnt(3)
    v_add3_u32 v152, v152, v153, v154
    v_and_b32 v152, 127, v152
    v_lshl_add_u32 v152, v152, 2, v155
    s_waitcnt lgkmcnt(2)
    v_add3_u32 v160, v160, v161, v162
    v_and_b32 v160, 127, v160
    v_lshl_add_u32 v160, v160, 2, v163
    s_waitcnt lgkmcnt(1)
    v_add3_u32 v168, v168, v169, v170
    v_and_b32 v168, 127, v168
    v_lshl_add_u32 v168, v168, 2, v171
    s_waitcnt lgkmcnt(0)
    v_add3_u32 v176, v176, v177, v178
    v_and_b32 v176, 127, v176
    v_lshl_add_u32 v176, v176, 2, v179
    s_mov_b64 exec, s[76:77]
    ds_write_b32 v152, v150 offset:4096
    s_mov_b64 exec, s[78:79]
    ds_write_b32 v160, v158 offset:4096
    s_mov_b64 exec, s[80:81]
    ds_write_b32 v168, v166 offset:4096
    s_mov_b64 exec, s[82:83]
    ds_write_b32 v176, v174 offset:4096
    s_mov_b64 exec, 1
    ds_max_u32 v52, v53 offset:640
    s_mov_b64 exec, -1
    s_cmp_lg_u32 s56, 0
    s_cbranch_scc1 PAY_SLOW
    s_waitcnt vmcnt(0)
LATECHK:
    v_add3_u32 v68, v212, v213, v214
    v_add_u32 v68, v68, v215
    s_nop 1
    v_add_u32_dpp v68, v68, v68 quad_perm:[1,0,3,2] row_mask:0xf bank_mask:0xf
    v_xor_b32 v69, s67, v212
    v_and_b32 v69, 0x7ff, v69
    v_add_u32 v69, -1, v69
    v_cmp_ne_u32 vcc, v202, v68
    v_cmp_gt_u32 s[84:85], 40, v69
    v_cmp_ne_u32 s[88:89], 0, v213
    s_cbranch_vccnz RELATE
    s_or_b64 s[88:89], s[84:85], s[88:89]
    s_cbranch_scc1 LATE_PRE
LATE_OK:
    s_mov_b64 exec, s[76:77]
    s_cbranch_execz PAY_OUT
    buffer_load_dwordx4 v[116:119], v151, s[8:11], 0 offen sc1
    s_mov_b64 exec, s[78:79]
    s_cbranch_execz PAY_OUT
    buffer_load_dwordx4 v[120:123], v159, s[8:11], 0 offen sc1
    s_mov_b64 exec, s[80:81]
    s_cbranch_execz PAY_OUT
    buffer_load_dwordx4 v[124:127], v167, s[8:11], 0 offen sc1
    s_mov_b64 exec, s[82:83]
    s_cbranch_execz PAY_OUT
    buffer_load_dwordx4 v[128:131], v175, s[8:11], 0 offen sc1
PAY_OUT:
    s_mov_b64 exec, -1
PAY_JOIN:
    s_waitcnt lgkmcnt(0)
    s_barrier
    ds_read_b128 v[180:183], v239 offset:4096
    ds_read_b128 v[184:187], v239 offset:4112
    v_lshlrev_b32 v152, 2, v152
    v_lshlrev_b32 v160, 2, v160
    v_lshlrev_b32 v168, 2, v168
    v_lshlrev_b32 v176, 2, v176
    v_add_u32 v200, s64, v3
    v_mov_b32 v201, s64
    s_waitcnt lgkmcnt(1)
    v_and_b32 v180, 16776192, v180
    buffer_load_dwordx4 v[52:55], v180, s[4:7], 0 offen
    v_and_b32 v181, 16776192, v181
    buffer_load_dwordx4 v[56:59], v181, s[4:7], 0 offen
    v_and_b32 v182, 16776192, v182
    buffer_load_dwordx4 v[60:63], v182, s[4:7], 0 offen
    v_and_b32 v183, 16776192, v183
    buffer_load_dwordx4 v[64:67], v183, s[4:7], 0 offen
    s_waitcnt lgkmcnt(0)
    v_and_b32 v184, 16776192, v184
    v_and_b32 v185, 16776192, v185
    v_and_b32 v186, 16776192, v186
    v_and_b32 v187, 16776192, v187
    s_waitcnt vmcnt(4)
    s_mov_b64 exec, s[76:77]
    ds_write_b128 v152, v[116:119] offset:8192
    s_mov_b64 exec, s[78:79]
    ds_write_b128 v160, v[120:123] offset:8192
    s_mov_b64 exec, s[80:81]
    ds_write_b128 v168, v[124:127] offset:8192
    s_mov_b64 exec, s[82:83]
    ds_write_b128 v176, v[128:131] offset:8192
    s_mov_b64 exec, -1
    s_cmp_lg_u64 s[88:89], 0
    s_cbranch_scc1 LATE_POST
LATE_END:
    s_waitcnt lgkmcnt(0)
    s_barrier
    ds_read_b128 v[244:247], v234 offset:8192
    ds_read_b32 v253, v233 offset:640
    ds_read2st64_b32 v[242:243], v232 offset0:16 offset1:17
    ds_read_b128 v[248:251], v234 offset:9216
    buffer_load_dwordx4 v[68:71], v184, s[4:7], 0 offen
    buffer_load_dwordx4 v[72:75], v185, s[4:7], 0 offen
    buffer_load_dwordx4 v[76:79], v186, s[4:7], 0 offen
    buffer_load_dwordx4 v[80:83], v187, s[4:7], 0 offen
    s_waitcnt lgkmcnt(3)
    v_mfma_f32_4x4x4_16b_bf16 v[132:135], v[196:197], v[244:245], 0 cbsz:4 abid:0
    v_mfma_f32_4x4x4_16b_bf16 v[136:139], v[196:197], v[244:245], 0 cbsz:4 abid:1
    v_mfma_f32_4x4x4_16b_bf16 v[140:143], v[196:197], v[244:245], 0 cbsz:4 abid:2
    v_mfma_f32_4x4x4_16b_bf16 v[144:147], v[196:197], v[244:245], 0 cbsz:4 abid:3
    v_mfma_f32_4x4x4_16b_bf16 v[148:151], v[246:247], v[188:189], 0 cbsz:4 abid:0
    v_mfma_f32_4x4x4_16b_bf16 v[152:155], v[246:247], v[190:191], 0 cbsz:4 abid:0
    s_nop 0
    v_mfma_f32_4x4x4_16b_bf16 v[148:151], v[246:247], v[192:193], v[148:151] cbsz:4 abid:0
    v_mfma_f32_4x4x4_16b_bf16 v[152:155], v[246:247], v[194:195], v[152:155] cbsz:4 abid:0
    s_waitcnt lgkmcnt(1)
    v_readlane_b32 s58, v253, s55
    v_cmp_lt_u32 vcc, 128, v253
    s_and_b32 s59, vcc_lo, 0x1ff
    s_cbranch_scc1 SLOW_ENTER
    ds_write_b64 v237, v[246:247] offset:128
    v_and_b32 v252, 16776192, v242
    ds_write_b8 v236, v242 offset:352
    ds_write_b32 v235, v252 offset:176
    v_cvt_pk_bf16_f32 v116, v132, v133
    v_cvt_pk_bf16_f32 v117, v134, v135
    v_cvt_pk_bf16_f32 v118, v136, v137
    v_cvt_pk_bf16_f32 v119, v138, v139
    v_cvt_pk_bf16_f32 v120, v140, v141
    v_cvt_pk_bf16_f32 v121, v142, v143
    v_cvt_pk_bf16_f32 v122, v144, v145
    v_cvt_pk_bf16_f32 v123, v146, v147
    ds_write_b128 v238, v[116:119] offset:0
    ds_write_b128 v238, v[120:123] offset:16
    ds_read2_b64 v[180:183], v200 offset0:0 offset1:40
    ds_read_b128 v[184:187], v201 offset:560
    v_exp_f32 v164, v148
    v_exp_f32 v165, v149
    v_exp_f32 v166, v150
    v_exp_f32 v167, v151
    v_exp_f32 v168, v152
    v_exp_f32 v169, v153
    v_exp_f32 v170, v154
    v_exp_f32 v171, v155
    s_add_u32 s58, s58, 3
    s_lshr_b32 s58, s58, 2
    s_mov_b32 s60, 1
    v_pk_fma_f32 v[164:165], v[164:165], v[198:199], v[198:199]
    v_pk_fma_f32 v[166:167], v[166:167], v[198:199], v[198:199]
    v_pk_fma_f32 v[168:169], v[168:169], v[198:199], v[198:199]
    v_pk_fma_f32 v[170:171], v[170:171], v[198:199], v[198:199]
    s_setprio 1
LOOP:
    s_cmp_lt_u32 s58, 3
    s_waitcnt vmcnt(4) lgkmcnt(0)
    s_cbranch_scc1 DRAIN0
BACK0:
    v_readlane_b32 s65, v182, 4
    v_mfma_f32_4x4x4_16b_bf16 v[156:159], v[182:183], v[188:189], 0 cbsz:4 abid:0
    v_rcp_f32 v164, v164
    v_mfma_f32_4x4x4_16b_bf16 v[160:163], v[182:183], v[190:191], 0 cbsz:4 abid:0
    v_rcp_f32 v165, v165
    v_mfma_f32_4x4x4_16b_bf16 v[156:159], v[182:183], v[192:193], v[156:159] cbsz:4 abid:0
    v_rcp_f32 v166, v166
    v_mfma_f32_4x4x4_16b_bf16 v[160:163], v[182:183], v[194:195], v[160:163] cbsz:4 abid:0
    v_rcp_f32 v167, v167
    v_mfma_f32_4x4x4_16b_bf16 v[116:119], v[180:181], v[52:53], 0 cbsz:4 abid:0
    v_rcp_f32 v168, v168
    v_mfma_f32_4x4x4_16b_bf16 v[120:123], v[180:181], v[54:55], 0 cbsz:4 abid:0
    v_rcp_f32 v169, v169
    v_mfma_f32_4x4x4_16b_bf16 v[124:127], v[180:181], v[56:57], 0 cbsz:4 abid:1
    v_rcp_f32 v170, v170
    v_mfma_f32_4x4x4_16b_bf16 v[128:131], v[180:181], v[58:59], 0 cbsz:4 abid:1
    v_rcp_f32 v171, v171
    v_mfma_f32_4x4x4_16b_bf16 v[132:135], v[180:181], v[60:61], 0 cbsz:4 abid:2
    v_exp_f32 v172, v156
    v_mfma_f32_4x4x4_16b_bf16 v[136:139], v[180:181], v[62:63], 0 cbsz:4 abid:2
    v_exp_f32 v173, v157
    v_mfma_f32_4x4x4_16b_bf16 v[140:143], v[180:181], v[64:65], 0 cbsz:4 abid:3
    v_exp_f32 v174, v158
    v_mfma_f32_4x4x4_16b_bf16 v[144:147], v[180:181], v[66:67], 0 cbsz:4 abid:3
    v_exp_f32 v175, v159
    ds_read2_b64 v[180:183], v200 offset0:24 offset1:64
    s_cbranch_scc1 NOLD0
    buffer_load_dwordx4 v[52:55], v184, s[4:7], 0 offen
    buffer_load_dwordx4 v[56:59], v185, s[4:7], 0 offen
    buffer_load_dwordx4 v[60:63], v186, s[4:7], 0 offen
    buffer_load_dwordx4 v[64:67], v187, s[4:7], 0 offen
    ds_read_b128 v[184:187], v201 offset:752
NOLD0:
    v_exp_f32 v176, v160
    v_exp_f32 v177, v161
    v_exp_f32 v178, v162
    v_exp_f32 v179, v163
    v_pk_mul_f32 v[164:165], v[164:165], v[148:149]
    v_pk_mul_f32 v[166:167], v[166:167], v[150:151]
    v_pk_mul_f32 v[168:169], v[168:169], v[152:153]
    v_pk_mul_f32 v[170:171], v[170:171], v[154:155]
    v_pk_fma_f32 v[172:173], v[172:173], v[198:199], v[198:199]
    v_pk_fma_f32 v[174:175], v[174:175], v[198:199], v[198:199]
    v_pk_fma_f32 v[176:177], v[176:177], v[198:199], v[198:199]
    v_pk_fma_f32 v[178:179], v[178:179], v[198:199], v[198:199]
    s_set_gpr_idx_on s65, gpr_idx(SRC2,DST)
    v_pk_fma_f32 v[4:5], v[164:165], v[116:117], v[4:5] op_sel:[0,0,0] op_sel_hi:[0,1,1]
    s_lshr_b32 s65, s65, 8
    v_pk_fma_f32 v[6:7], v[164:165], v[118:119], v[6:7] op_sel:[0,0,0] op_sel_hi:[0,1,1]
    v_pk_fma_f32 v[8:9], v[168:169], v[120:121], v[8:9] op_sel:[0,0,0] op_sel_hi:[0,1,1]
    v_pk_fma_f32 v[10:11], v[168:169], v[122:123], v[10:11] op_sel:[0,0,0] op_sel_hi:[0,1,1]
    s_set_gpr_idx_idx s65
    v_pk_fma_f32 v[4:5], v[164:165], v[124:125], v[4:5] op_sel:[1,0,0] op_sel_hi:[1,1,1]
    s_lshr_b32 s65, s65, 8
    v_pk_fma_f32 v[6:7], v[164:165], v[126:127], v[6:7] op_sel:[1,0,0] op_sel_hi:[1,1,1]
    v_pk_fma_f32 v[8:9], v[168:169], v[128:129], v[8:9] op_sel:[1,0,0] op_sel_hi:[1,1,1]
    v_pk_fma_f32 v[10:11], v[168:169], v[130:131], v[10:11] op_sel:[1,0,0] op_sel_hi:[1,1,1]
    s_set_gpr_idx_idx s65
    v_pk_fma_f32 v[4:5], v[166:167], v[132:133], v[4:5] op_sel:[0,0,0] op_sel_hi:[0,1,1]
    s_lshr_b32 s65, s65, 8
    v_pk_fma_f32 v[6:7], v[166:167], v[134:135], v[6:7] op_sel:[0,0,0] op_sel_hi:[0,1,1]
    v_pk_fma_f32 v[8:9], v[170:171], v[136:137], v[8:9] op_sel:[0,0,0] op_sel_hi:[0,1,1]
    v_pk_fma_f32 v[10:11], v[170:171], v[138:139], v[10:11] op_sel:[0,0,0] op_sel_hi:[0,1,1]
    s_set_gpr_idx_idx s65
    v_pk_fma_f32 v[4:5], v[166:167], v[140:141], v[4:5] op_sel:[1,0,0] op_sel_hi:[1,1,1]
    v_pk_fma_f32 v[6:7], v[166:167], v[142:143], v[6:7] op_sel:[1,0,0] op_sel_hi:[1,1,1]
    v_pk_fma_f32 v[8:9], v[170:171], v[144:145], v[8:9] op_sel:[1,0,0] op_sel_hi:[1,1,1]
    v_pk_fma_f32 v[10:11], v[170:171], v[146:147], v[10:11] op_sel:[1,0,0] op_sel_hi:[1,1,1]
    s_set_gpr_idx_off
    s_sub_u32 s58, s58, 1
    s_cmp_lt_u32 s58, 3
    s_waitcnt vmcnt(4) lgkmcnt(0)
    s_cbranch_scc1 DRAIN1
BACK1:
    v_readlane_b32 s65, v182, 4
    v_mfma_f32_4x4x4_16b_bf16 v[148:151], v[182:183], v[188:189], 0 cbsz:4 abid:0
    v_rcp_f32 v172, v172
    v_mfma_f32_4x4x4_16b_bf16 v[152:155], v[182:183], v[190:191], 0 cbsz:4 abid:0
    v_rcp_f32 v173, v173
    v_mfma_f32_4x4x4_16b_bf16 v[148:151], v[182:183], v[192:193], v[148:151] cbsz:4 abid:0
    v_rcp_f32 v174, v174
    v_mfma_f32_4x4x4_16b_bf16 v[152:155], v[182:183], v[194:195], v[152:155] cbsz:4 abid:0
    v_rcp_f32 v175, v175
    v_mfma_f32_4x4x4_16b_bf16 v[116:119], v[180:181], v[68:69], 0 cbsz:4 abid:0
    v_rcp_f32 v176, v176
    v_mfma_f32_4x4x4_16b_bf16 v[120:123], v[180:181], v[70:71], 0 cbsz:4 abid:0
    v_rcp_f32 v177, v177
    v_mfma_f32_4x4x4_16b_bf16 v[124:127], v[180:181], v[72:73], 0 cbsz:4 abid:1
    v_rcp_f32 v178, v178
    v_mfma_f32_4x4x4_16b_bf16 v[128:131], v[180:181], v[74:75], 0 cbsz:4 abid:1
    v_rcp_f32 v179, v179
    v_mfma_f32_4x4x4_16b_bf16 v[132:135], v[180:181], v[76:77], 0 cbsz:4 abid:2
    v_exp_f32 v164, v148
    v_mfma_f32_4x4x4_16b_bf16 v[136:139], v[180:181], v[78:79], 0 cbsz:4 abid:2
    v_exp_f32 v165, v149
    v_mfma_f32_4x4x4_16b_bf16 v[140:143], v[180:181], v[80:81], 0 cbsz:4 abid:3
    v_exp_f32 v166, v150
    v_mfma_f32_4x4x4_16b_bf16 v[144:147], v[180:181], v[82:83], 0 cbsz:4 abid:3
    v_exp_f32 v167, v151
    ds_read2_b64 v[180:183], v200 offset0:48 offset1:88
    s_cbranch_scc1 NOLD1
    buffer_load_dwordx4 v[68:71], v184, s[4:7], 0 offen
    buffer_load_dwordx4 v[72:75], v185, s[4:7], 0 offen
    buffer_load_dwordx4 v[76:79], v186, s[4:7], 0 offen
    buffer_load_dwordx4 v[80:83], v187, s[4:7], 0 offen
    ds_read_b128 v[184:187], v201 offset:944
NOLD1:
    v_exp_f32 v168, v152
    v_exp_f32 v169, v153
    v_exp_f32 v170, v154
    v_exp_f32 v171, v155
    v_pk_mul_f32 v[172:173], v[172:173], v[156:157]
    v_pk_mul_f32 v[174:175], v[174:175], v[158:159]
    v_pk_mul_f32 v[176:177], v[176:177], v[160:161]
    v_pk_mul_f32 v[178:179], v[178:179], v[162:163]
    v_pk_fma_f32 v[164:165], v[164:165], v[198:199], v[198:199]
    v_pk_fma_f32 v[166:167], v[166:167], v[198:199], v[198:199]
    v_pk_fma_f32 v[168:169], v[168:169], v[198:199], v[198:199]
    v_pk_fma_f32 v[170:171], v[170:171], v[198:199], v[198:199]
    s_set_gpr_idx_on s65, gpr_idx(SRC2,DST)
    v_pk_fma_f32 v[4:5], v[172:173], v[116:117], v[4:5] op_sel:[0,0,0] op_sel_hi:[0,1,1]
    s_lshr_b32 s65, s65, 8
    v_pk_fma_f32 v[6:7], v[172:173], v[118:119], v[6:7] op_sel:[0,0,0] op_sel_hi:[0,1,1]
    v_pk_fma_f32 v[8:9], v[176:177], v[120:121], v[8:9] op_sel:[0,0,0] op_sel_hi:[0,1,1]
    v_pk_fma_f32 v[10:11], v[176:177], v[122:123], v[10:11] op_sel:[0,0,0] op_sel_hi:[0,1,1]
    s_set_gpr_idx_idx s65
    v_pk_fma_f32 v[4:5], v[172:173], v[124:125], v[4:5] op_sel:[1,0,0] op_sel_hi:[1,1,1]
    s_lshr_b32 s65, s65, 8
    v_pk_fma_f32 v[6:7], v[172:173], v[126:127], v[6:7] op_sel:[1,0,0] op_sel_hi:[1,1,1]
    v_pk_fma_f32 v[8:9], v[176:177], v[128:129], v[8:9] op_sel:[1,0,0] op_sel_hi:[1,1,1]
    v_pk_fma_f32 v[10:11], v[176:177], v[130:131], v[10:11] op_sel:[1,0,0] op_sel_hi:[1,1,1]
    s_set_gpr_idx_idx s65
    v_pk_fma_f32 v[4:5], v[174:175], v[132:133], v[4:5] op_sel:[0,0,0] op_sel_hi:[0,1,1]
    s_lshr_b32 s65, s65, 8
    v_pk_fma_f32 v[6:7], v[174:175], v[134:135], v[6:7] op_sel:[0,0,0] op_sel_hi:[0,1,1]
    v_pk_fma_f32 v[8:9], v[178:179], v[136:137], v[8:9] op_sel:[0,0,0] op_sel_hi:[0,1,1]
    v_pk_fma_f32 v[10:11], v[178:179], v[138:139], v[10:11] op_sel:[0,0,0] op_sel_hi:[0,1,1]
    s_set_gpr_idx_idx s65
    v_pk_fma_f32 v[4:5], v[174:175], v[140:141], v[4:5] op_sel:[1,0,0] op_sel_hi:[1,1,1]
    v_pk_fma_f32 v[6:7], v[174:175], v[142:143], v[6:7] op_sel:[1,0,0] op_sel_hi:[1,1,1]
    v_pk_fma_f32 v[8:9], v[178:179], v[144:145], v[8:9] op_sel:[1,0,0] op_sel_hi:[1,1,1]
    v_pk_fma_f32 v[10:11], v[178:179], v[146:147], v[10:11] op_sel:[1,0,0] op_sel_hi:[1,1,1]
    s_set_gpr_idx_off
    v_add_u32 v200, 384, v200
    v_add_u32 v201, 384, v201
    s_sub_u32 s58, s58, 1
    s_cmp_eq_u32 s60, 0
    s_cbranch_scc1 LOOP
    s_mov_b32 s60, 0
    v_mfma_f32_4x4x4_16b_bf16 v[132:135], v[196:197], v[248:249], 0 cbsz:4 abid:0
    v_mfma_f32_4x4x4_16b_bf16 v[136:139], v[196:197], v[248:249], 0 cbsz:4 abid:1
    v_mfma_f32_4x4x4_16b_bf16 v[140:143], v[196:197], v[248:249], 0 cbsz:4 abid:2
    v_mfma_f32_4x4x4_16b_bf16 v[144:147], v[196:197], v[248:249], 0 cbsz:4 abid:3
    ds_write_b64 v237, v[250:251] offset:3200
    v_and_b32 v252, 16776192, v243
    ds_write_b8 v236, v243 offset:3424
    ds_write_b32 v235, v252 offset:3248
    v_cvt_pk_bf16_f32 v116, v132, v133
    v_cvt_pk_bf16_f32 v117, v134, v135
    v_cvt_pk_bf16_f32 v118, v136, v137
    v_cvt_pk_bf16_f32 v119, v138, v139
    v_cvt_pk_bf16_f32 v120, v140, v141
    v_cvt_pk_bf16_f32 v121, v142, v143
    v_cvt_pk_bf16_f32 v122, v144, v145
    v_cvt_pk_bf16_f32 v123, v146, v147
    ds_write_b128 v238, v[116:119] offset:3072
    ds_write_b128 v238, v[120:123] offset:3088
    s_branch LOOP
DRAIN0:
    s_cmp_eq_u32 s58, 2
    s_cbranch_scc1 BACK0
    s_cmp_eq_u32 s58, 1
    s_waitcnt vmcnt(0)
    s_cbranch_scc1 BACK0
    s_branch LIST_DONE
DRAIN1:
    s_cmp_eq_u32 s58, 2
    s_cbranch_scc1 BACK1
    s_cmp_eq_u32 s58, 1
    s_waitcnt vmcnt(0)
    s_cbranch_scc1 BACK1
LIST_DONE:
    s_cmp_lg_u32 s56, 0
    s_cbranch_scc1 SLOW_NEXT
MIX:
    s_setprio 0
    ds_read_b32 v208, v221 offset:2048
    ds_read_b32 v209, v221 offset:2064
    ds_read_b32 v210, v221 offset:2080
    ds_read_b32 v211, v221 offset:2096
    ds_read_b32 v212, v221 offset:2112
    v_cvt_pk_bf16_f32 v4, v4, v8
    v_cvt_pk_bf16_f32 v5, v5, v9
    v_cvt_pk_bf16_f32 v6, v6, v10
    v_cvt_pk_bf16_f32 v7, v7, v11
    ds_write2_b32 v226, v4, v5 offset0:0 offset1:68
    ds_write2_b32 v226, v6, v7 offset0:136 offset1:204
    v_add_u32 v226, 1088, v226
    v_cvt_pk_bf16_f32 v12, v12, v16
    v_cvt_pk_bf16_f32 v13, v13, v17
    v_cvt_pk_bf16_f32 v14, v14, v18
    v_cvt_pk_bf16_f32 v15, v15, v19
    ds_write2_b32 v226, v12, v13 offset0:0 offset1:68
    ds_write2_b32 v226, v14, v15 offset0:136 offset1:204
    v_add_u32 v226, 1088, v226
    v_cvt_pk_bf16_f32 v20, v20, v24
    v_cvt_pk_bf16_f32 v21, v21, v25
    v_cvt_pk_bf16_f32 v22, v22, v26
    v_cvt_pk_bf16_f32 v23, v23, v27
    ds_write2_b32 v226, v20, v21 offset0:0 offset1:68
    ds_write2_b32 v226, v22, v23 offset0:136 offset1:204
    s_waitcnt lgkmcnt(4)
    v_add_u32 v226, 1088, v226
    v_cvt_pk_bf16_f32 v28, v28, v32
    v_cvt_pk_bf16_f32 v29, v29, v33
    v_cvt_pk_bf16_f32 v30, v30, v34
    v_cvt_pk_bf16_f32 v31, v31, v35
    ds_write2_b32 v226, v28, v29 offset0:0 offset1:68
    ds_write2_b32 v226, v30, v31 offset0:136 offset1:204
    v_add_u32 v226, 1088, v226
    v_cvt_pk_bf16_f32 v36, v36, v40
    v_cvt_pk_bf16_f32 v37, v37, v41
    v_cvt_pk_bf16_f32 v38, v38, v42
    v_cvt_pk_bf16_f32 v39, v39, v43
    ds_write2_b32 v226, v36, v37 offset0:0 offset1:68
    ds_write2_b32 v226, v38, v39 offset0:136 offset1:204
    v_mov_b32 v184, 1
    s_mov_b64 exec, 1
    ds_add_u32 v227, v184 offset:768
    s_or_b32 s61, s55, s2
    s_cbranch_scc1 NOBUMP
    buffer_store_dword v203, off, s[8:11], 0 sc1
NOBUMP:
    s_mov_b64 exec, -1
GSYNC:
    ds_read_b32 v185, v227 offset:768
    s_waitcnt lgkmcnt(0)
    v_cmp_ne_u32 vcc, 4, v185
    s_cbranch_vccnz GWAIT
    ds_read_b128 v[52:55], v225 offset:0
    ds_read_b128 v[56:59], v225 offset:64
    ds_read_b128 v[60:63], v225 offset:128
    ds_read_b128 v[64:67], v225 offset:192
    ds_read_b128 v[68:71], v225 offset:4352
    ds_read_b128 v[72:75], v225 offset:4416
    ds_read_b128 v[76:79], v225 offset:4480
    ds_read_b128 v[80:83], v225 offset:4544
    ds_read_b128 v[116:119], v225 offset:8704
    ds_read_b128 v[120:123], v225 offset:8768
    ds_read_b128 v[124:127], v225 offset:8832
    ds_read_b128 v[128:131], v225 offset:8896
    v_lshl_add_u32 v208, v208, 15, v220
    v_lshl_add_u32 v209, v209, 15, v220
    v_lshl_add_u32 v210, v210, 15, v220
    v_lshl_add_u32 v211, v211, 15, v220
    v_lshl_add_u32 v212, v212, 15, v220
    s_waitcnt lgkmcnt(11)
    v_mfma_f32_16x16x32_bf16 v[164:167], v[52:55], v[84:87], 0
    v_mfma_f32_16x16x32_bf16 v[168:171], v[52:55], v[88:91], 0
    ds_read_b128 v[132:135], v225 offset:13056
    s_waitcnt lgkmcnt(11)
    v_mfma_f32_16x16x32_bf16 v[164:167], v[56:59], v[92:95], v[164:167]
    v_mfma_f32_16x16x32_bf16 v[168:171], v[56:59], v[96:99], v[168:171]
    ds_read_b128 v[136:139], v225 offset:13120
    s_waitcnt lgkmcnt(11)
    v_mfma_f32_16x16x32_bf16 v[164:167], v[60:63], v[100:103], v[164:167]
    v_mfma_f32_16x16x32_bf16 v[168:171], v[60:63], v[104:107], v[168:171]
    ds_read_b128 v[140:143], v225 offset:13184
    s_waitcnt lgkmcnt(11)
    v_mfma_f32_16x16x32_bf16 v[164:167], v[64:67], v[108:111], v[164:167]
    v_mfma_f32_16x16x32_bf16 v[168:171], v[64:67], v[112:115], v[168:171]
    ds_read_b128 v[144:147], v225 offset:13248
    s_waitcnt lgkmcnt(11)
    v_mfma_f32_16x16x32_bf16 v[172:175], v[68:71], v[84:87], 0
    v_mfma_f32_16x16x32_bf16 v[176:179], v[68:71], v[88:91], 0
    ds_read_b128 v[148:151], v225 offset:17408
    s_waitcnt lgkmcnt(11)
    v_mfma_f32_16x16x32_bf16 v[172:175], v[72:75], v[92:95], v[172:175]
    v_mfma_f32_16x16x32_bf16 v[176:179], v[72:75], v[96:99], v[176:179]
    ds_read_b128 v[152:155], v225 offset:17472
    s_waitcnt lgkmcnt(11)
    v_mfma_f32_16x16x32_bf16 v[172:175], v[76:79], v[100:103], v[172:175]
    v_mfma_f32_16x16x32_bf16 v[176:179], v[76:79], v[104:107], v[176:179]
    ds_read_b128 v[156:159], v225 offset:17536
    v_cvt_pk_bf16_f32 v232, v164, v165
    v_cvt_pk_bf16_f32 v233, v166, v167
    v_cvt_pk_bf16_f32 v234, v168, v169
    v_cvt_pk_bf16_f32 v235, v170, v171
    buffer_store_dwordx4 v[232:235], v208, s[12:15], 0 offen sc1
    s_waitcnt lgkmcnt(11)
    v_mfma_f32_16x16x32_bf16 v[172:175], v[80:83], v[108:111], v[172:175]
    v_mfma_f32_16x16x32_bf16 v[176:179], v[80:83], v[112:115], v[176:179]
    ds_read_b128 v[160:163], v225 offset:17600
    s_waitcnt lgkmcnt(11)
    v_mfma_f32_16x16x32_bf16 v[164:167], v[116:119], v[84:87], 0
    v_mfma_f32_16x16x32_bf16 v[168:171], v[116:119], v[88:91], 0
    s_waitcnt lgkmcnt(10)
    v_mfma_f32_16x16x32_bf16 v[164:167], v[120:123], v[92:95], v[164:167]
    v_mfma_f32_16x16x32_bf16 v[168:171], v[120:123], v[96:99], v[168:171]
    s_waitcnt lgkmcnt(9)
    v_mfma_f32_16x16x32_bf16 v[164:167], v[124:127], v[100:103], v[164:167]
    v_mfma_f32_16x16x32_bf16 v[168:171], v[124:127], v[104:107], v[168:171]
    v_cvt_pk_bf16_f32 v236, v172, v173
    v_cvt_pk_bf16_f32 v237, v174, v175
    v_cvt_pk_bf16_f32 v238, v176, v177
    v_cvt_pk_bf16_f32 v239, v178, v179
    buffer_store_dwordx4 v[236:239], v209, s[12:15], 0 offen sc1
    s_waitcnt lgkmcnt(8)
    v_mfma_f32_16x16x32_bf16 v[164:167], v[128:131], v[108:111], v[164:167]
    v_mfma_f32_16x16x32_bf16 v[168:171], v[128:131], v[112:115], v[168:171]
    s_waitcnt lgkmcnt(7)
    v_mfma_f32_16x16x32_bf16 v[172:175], v[132:135], v[84:87], 0
    v_mfma_f32_16x16x32_bf16 v[176:179], v[132:135], v[88:91], 0
    s_waitcnt lgkmcnt(6)
    v_mfma_f32_16x16x32_bf16 v[172:175], v[136:139], v[92:95], v[172:175]
    v_mfma_f32_16x16x32_bf16 v[176:179], v[136:139], v[96:99], v[176:179]
    s_waitcnt lgkmcnt(5)
    v_mfma_f32_16x16x32_bf16 v[172:175], v[140:143], v[100:103], v[172:175]
    v_mfma_f32_16x16x32_bf16 v[176:179], v[140:143], v[104:107], v[176:179]
    v_cvt_pk_bf16_f32 v240, v164, v165
    v_cvt_pk_bf16_f32 v241, v166, v167
    v_cvt_pk_bf16_f32 v242, v168, v169
    v_cvt_pk_bf16_f32 v243, v170, v171
    buffer_store_dwordx4 v[240:243], v210, s[12:15], 0 offen sc1
    s_waitcnt lgkmcnt(4)
    v_mfma_f32_16x16x32_bf16 v[172:175], v[144:147], v[108:111], v[172:175]
    v_mfma_f32_16x16x32_bf16 v[176:179], v[144:147], v[112:115], v[176:179]
    s_waitcnt lgkmcnt(3)
    v_mfma_f32_16x16x32_bf16 v[164:167], v[148:151], v[84:87], 0
    v_mfma_f32_16x16x32_bf16 v[168:171], v[148:151], v[88:91], 0
    s_waitcnt lgkmcnt(2)
    v_mfma_f32_16x16x32_bf16 v[164:167], v[152:155], v[92:95], v[164:167]
    v_mfma_f32_16x16x32_bf16 v[168:171], v[152:155], v[96:99], v[168:171]
    s_waitcnt lgkmcnt(1)
    v_mfma_f32_16x16x32_bf16 v[164:167], v[156:159], v[100:103], v[164:167]
    v_mfma_f32_16x16x32_bf16 v[168:171], v[156:159], v[104:107], v[168:171]
    v_cvt_pk_bf16_f32 v244, v172, v173
    v_cvt_pk_bf16_f32 v245, v174, v175
    v_cvt_pk_bf16_f32 v246, v176, v177
    v_cvt_pk_bf16_f32 v247, v178, v179
    buffer_store_dwordx4 v[244:247], v211, s[12:15], 0 offen sc1
    s_waitcnt lgkmcnt(0)
    v_mfma_f32_16x16x32_bf16 v[164:167], v[160:163], v[108:111], v[164:167]
    v_mfma_f32_16x16x32_bf16 v[168:171], v[160:163], v[112:115], v[168:171]
    s_nop 6
    v_cvt_pk_bf16_f32 v248, v164, v165
    v_cvt_pk_bf16_f32 v249, v166, v167
    v_cvt_pk_bf16_f32 v250, v168, v169
    v_cvt_pk_bf16_f32 v251, v170, v171
    buffer_store_dwordx4 v[248:251], v212, s[12:15], 0 offen sc1
K_END:
    s_endpgm
GWAIT:
    s_sleep 1
    s_branch GSYNC
REPOLL:
    s_add_u32 s58, s58, s63
    s_lshr_b32 s84, s58, 16
    s_cbranch_scc1 GIVEUP
    buffer_load_dwordx4 v[208:211], v204, s[8:11], s93 offen sc1
    s_waitcnt vmcnt(0)
    s_branch POLL
GIVEUP:
    v_mov_b32 v208, 0
    v_mov_b32 v209, 0
    v_mov_b32 v210, 0
    v_mov_b32 v211, 0
    v_mov_b32 v68, 672
    ds_write_b32 v68, v68
    s_branch BATCH
RELATE:
    s_add_u32 s58, s58, 1
    s_lshr_b32 s84, s58, 16
    s_cbranch_scc1 GIVEUP2
    buffer_load_dwordx4 v[212:215], v205, s[8:11], s75 offen sc1
    s_waitcnt vmcnt(0)
    s_branch LATECHK
GIVEUP2:
    v_mov_b32 v68, 672
    ds_write_b32 v68, v68
    s_mov_b64 s[88:89], 0
    s_branch LATE_OK
LATE_PRE:
    v_cndmask_b32 v215, v215, 0, s[86:87]
    v_and_b32 v68, 63, v213
    v_cmp_eq_u32 vcc, 63, v68
    s_cbranch_vccnz GIVEUP2
    s_mov_b64 s[88:89], 0
    v_xor_b32 v68, s67, v212
    v_and_b32 v68, 0x7ff, v68
    v_add_u32 v68, -1, v68
    v_cmp_gt_u32 vcc, 40, v68
    v_lshrrev_b32 v68, 25, v212
    v_lshl_add_u32 v68, v68, 4, v206
    s_mov_b64 s[94:95], vcc
    s_cbranch_vccz LATE_P0
    s_or_b64 s[88:89], s[88:89], vcc
    s_mov_b64 exec, vcc
    buffer_load_dwordx4 v[132:135], v68, s[8:11], 0 offen sc1
    s_mov_b64 exec, -1
LATE_P0:
    v_xor_b32 v68, s67, v213
    v_and_b32 v68, 0x7ff, v68
    v_add_u32 v68, -1, v68
    v_cmp_gt_u32 vcc, 40, v68
    v_lshrrev_b32 v68, 25, v213
    v_lshl_add_u32 v68, v68, 4, v206
    s_mov_b64 s[96:97], vcc
    s_cbranch_vccz LATE_P1
    s_or_b64 s[88:89], s[88:89], vcc
    s_mov_b64 exec, vcc
    buffer_load_dwordx4 v[136:139], v68, s[8:11], 0 offen sc1
    s_mov_b64 exec, -1
LATE_P1:
    v_xor_b32 v68, s67, v214
    v_and_b32 v68, 0x7ff, v68
    v_add_u32 v68, -1, v68
    v_cmp_gt_u32 vcc, 40, v68
    v_lshrrev_b32 v68, 25, v214
    v_lshl_add_u32 v68, v68, 4, v206
    s_mov_b64 s[98:99], vcc
    s_cbranch_vccz LATE_P2
    s_or_b64 s[88:89], s[88:89], vcc
    s_mov_b64 exec, vcc
    buffer_load_dwordx4 v[140:143], v68, s[8:11], 0 offen sc1
    s_mov_b64 exec, -1
LATE_P2:
    v_xor_b32 v68, s67, v215
    v_and_b32 v68, 0x7ff, v68
    v_add_u32 v68, -1, v68
    v_cmp_gt_u32 vcc, 40, v68
    v_lshrrev_b32 v68, 25, v215
    v_lshl_add_u32 v68, v68, 4, v206
    s_mov_b64 s[100:101], vcc
    s_cbranch_vccz LATE_P3
    s_or_b64 s[88:89], s[88:89], vcc
    s_mov_b64 exec, vcc
    buffer_load_dwordx4 v[144:147], v68, s[8:11], 0 offen sc1
    s_mov_b64 exec, -1
LATE_P3:
    s_branch LATE_OK
LATE_POST:
    s_mov_b64 exec, s[94:95]
    s_cbranch_execz LATE_Q0
    v_and_b32 v148, 63, v212
    v_lshlrev_b32 v148, 3, v148
    ds_read_u16 v149, v148 offset:1528
    v_mov_b32 v150, 1
    v_lshrrev_b32 v153, 1, v212
    s_waitcnt lgkmcnt(0)
    v_lshrrev_b32 v148, 7, v149
    ds_add_rtn_u32 v151, v148, v150 offset:640
    v_bfi_b32 v153, s66, v149, v153
    v_and_b32 v149, 0xe00, v149
    s_waitcnt lgkmcnt(0)
    v_min_u32 v151, 127, v151
    v_lshl_add_u32 v151, v151, 2, v149
    ds_write_b32 v151, v153 offset:4096
    v_lshlrev_b32 v151, 2, v151
    ds_write_b128 v151, v[132:135] offset:8192
LATE_Q0:
    s_mov_b64 exec, s[96:97]
    s_cbranch_execz LATE_Q1
    v_and_b32 v148, 63, v213
    v_lshlrev_b32 v148, 3, v148
    ds_read_u16 v149, v148 offset:1528
    v_mov_b32 v150, 1
    v_lshrrev_b32 v153, 1, v213
    s_waitcnt lgkmcnt(0)
    v_lshrrev_b32 v148, 7, v149
    ds_add_rtn_u32 v151, v148, v150 offset:640
    v_bfi_b32 v153, s66, v149, v153
    v_and_b32 v149, 0xe00, v149
    s_waitcnt lgkmcnt(0)
    v_min_u32 v151, 127, v151
    v_lshl_add_u32 v151, v151, 2, v149
    ds_write_b32 v151, v153 offset:4096
    v_lshlrev_b32 v151, 2, v151
    ds_write_b128 v151, v[136:139] offset:8192
LATE_Q1:
    s_mov_b64 exec, s[98:99]
    s_cbranch_execz LATE_Q2
    v_and_b32 v148, 63, v214
    v_lshlrev_b32 v148, 3, v148
    ds_read_u16 v149, v148 offset:1528
    v_mov_b32 v150, 1
    v_lshrrev_b32 v153, 1, v214
    s_waitcnt lgkmcnt(0)
    v_lshrrev_b32 v148, 7, v149
    ds_add_rtn_u32 v151, v148, v150 offset:640
    v_bfi_b32 v153, s66, v149, v153
    v_and_b32 v149, 0xe00, v149
    s_waitcnt lgkmcnt(0)
    v_min_u32 v151, 127, v151
    v_lshl_add_u32 v151, v151, 2, v149
    ds_write_b32 v151, v153 offset:4096
    v_lshlrev_b32 v151, 2, v151
    ds_write_b128 v151, v[140:143] offset:8192
LATE_Q2:
    s_mov_b64 exec, s[100:101]
    s_cbranch_execz LATE_Q3
    v_and_b32 v148, 63, v215
    v_lshlrev_b32 v148, 3, v148
    ds_read_u16 v149, v148 offset:1528
    v_mov_b32 v150, 1
    v_lshrrev_b32 v153, 1, v215
    s_waitcnt lgkmcnt(0)
    v_lshrrev_b32 v148, 7, v149
    ds_add_rtn_u32 v151, v148, v150 offset:640
    v_bfi_b32 v153, s66, v149, v153
    v_and_b32 v149, 0xe00, v149
    s_waitcnt lgkmcnt(0)
    v_min_u32 v151, 127, v151
    v_lshl_add_u32 v151, v151, 2, v149
    ds_write_b32 v151, v153 offset:4096
    v_lshlrev_b32 v151, 2, v151
    ds_write_b128 v151, v[144:147] offset:8192
LATE_Q3:
    s_mov_b64 exec, -1
    s_branch LATE_END
SLOW_ENTER:
    s_mov_b32 s56, 1
    s_mov_b32 s62, 0
    s_branch SLOW_LOAD
PAY_SLOW:
    buffer_load_dwordx2 v[116:117], v206, s[16:19], 0 offen
    buffer_load_dwordx2 v[118:119], v206, s[20:23], 0 offen
    s_waitcnt vmcnt(0)
    s_branch PAY_JOIN
SLOW_NEXT:
    s_add_u32 s57, s57, 100
    s_cmp_ge_u32 s57, 160000
    s_cbranch_scc1 MIX
SLOW_LOAD:
    s_waitcnt vmcnt(0) lgkmcnt(0)
    s_barrier
    v_add_lshl_u32 v53, v0, s57, 2
    buffer_load_dword v54, v53, s[24:27], 0 offen
    buffer_load_dword v55, v53, s[28:31], 0 offen
    v_lshlrev_b32 v206, 1, v53
    v_mov_b32 v209, 0
    v_mov_b32 v210, 0
    v_mov_b32 v211, 0
    ds_write_b128 v207, v[216:219] offset:8192
    ds_write_b128 v207, v[216:219] offset:16384
    v_mov_b32 v58, 40
    v_mov_b32 v59, 40
    v_lshlrev_b32 v57, 3, v0
    ds_write_b64 v57, v[58:59] offset:4096
    ds_write_b64 v3, v[216:217] offset:0
    ds_write_b64 v3, v[216:217] offset:256
    v_cmp_gt_u32 vcc, 100, v0
    s_mov_b64 s[84:85], vcc
    s_waitcnt vmcnt(0)
    v_min_u32 v54, 9999, v54
    v_min_u32 v55, 9999, v55
    v_and_b32 v53, 255, v54
    v_cmp_eq_u32 vcc, s54, v53
    v_lshrrev_b32 v54, 8, v54
    v_or_b32 v54, 64, v54
    v_lshlrev_b32 v54, 3, v54
    v_lshl_or_b32 v54, v55, 10, v54
    v_and_or_b32 v54, v0, 7, v54
    s_and_b64 vcc, vcc, s[84:85]
    v_cndmask_b32 v208, 0, v54, vcc
    v_mov_b32 v151, 1
    v_mov_b32 v159, 1
    v_mov_b32 v167, 1
    v_mov_b32 v175, 1
    s_waitcnt lgkmcnt(0)
    s_barrier
    s_branch BATCH
.p2align 2
.type rank_table,@object
rank_table:
.long 0x3c0600, 0x140200, 0x0, 0x280400, 0x8c0e00, 0x900e08, 0x2c0408, 0x40008
.long 0x180208, 0x780c00, 0x640a00, 0x400608, 0x300410, 0x80010, 0x1c0210, 0x500800
.long 0x440610, 0x940e10, 0x540808, 0x680a08, 0x7c0c08, 0x580810, 0x800c10, 0x6c0a10
.long 0x840c18, 0x980e18, 0x700a18, 0x5c0818, 0x340418, 0xc0018, 0x200218, 0x480618
.long 0x100020, 0x240220, 0x380420, 0x4c0620, 0x600820, 0x740a20, 0x880c20, 0x9c0e20
.long 0x3c0600, 0x0, 0x140200, 0x280400, 0x2c0408, 0x180208, 0x40008, 0x8c0e00
.long 0x780c00, 0x400608, 0x640a00, 0x300410, 0x1c0210, 0x500800, 0x80010, 0x540808
.long 0x900e08, 0x7c0c08, 0x680a08, 0x440610, 0x6c0a10, 0x580810, 0x940e10, 0x800c10
.long 0x480618, 0x980e18, 0x840c18, 0x700a18, 0x340418, 0x200218, 0xc0018, 0x5c0818
.long 0x100020, 0x240220, 0x380420, 0x600820, 0x4c0620, 0x740a20, 0x880c20, 0x9c0e20
.size rank_table, 320
CODE_END:
.long 0
.section .rodata,"a"
.p2align 6
.amdhsa_kernel gather_scatter__tensor_product_equiv_tfn__graph_kernel
  .amdhsa_next_free_vgpr 254
  .amdhsa_next_free_sgpr 102
  .amdhsa_accum_offset 256
  .amdhsa_group_segment_fixed_size 0
  .amdhsa_kernarg_size 88
  .amdhsa_user_sgpr_count 2
  .amdhsa_user_sgpr_kernarg_segment_ptr 1
  .amdhsa_system_sgpr_workgroup_id_x 1
  .amdhsa_float_denorm_mode_32 3
.end_amdhsa_kernel
```
